```python
import torch

def _softmax(x, axis=-1):
    return torch.softmax(x, dim=axis)
def _gelu(x):
    return torch.nn.functional.gelu(x, approximate="tanh")
def _silu(x):
    return torch.nn.functional.silu(x)
def _sigmoid(x):
    return torch.sigmoid(x)
def _layernorm(x, axis=-1, eps=1e-5):
    m = x.mean(dim=axis, keepdim=True)
    v = x.var(dim=axis, keepdim=True, unbiased=False)
    return (x - m) / torch.sqrt(v + eps)
def _scatter_add(tgt, idx, src, axis=0):
    return tgt.clone().index_add_(axis, idx, src)
def _segment_sum(src, seg, n):
    out = torch.zeros((n,) + src.shape[1:], dtype=src.dtype)
    return out.index_add_(0, seg, src)
def _pad(x, pw):
    flat = tuple(v for pair in reversed(pw) for v in pair)
    return torch.nn.functional.pad(x, flat)

kernel_name = 'parallel_sum__sliding_block_cached__dense_activation_relu__decode'

def setup_inputs():

    _w = (lambda a: (lambda t: t.to(torch.bfloat16) if t.is_floating_point() else t)(torch.as_tensor(a)))
    def _A_setup():
        B, Sq, D = 1, 1, 640
        Hq, Hkv, Sk, Dh = 32, 32, 32768, 192
        assert Hq % Hkv == 0, (Hq, Hkv)
        return {
            "x": _w((lambda *s: torch.randn(*s, dtype=torch.bfloat16) * 0.05)(B, Sq, D)),
            "k_cache": _w((lambda *s: torch.randn(*s, dtype=torch.bfloat16) * 3.2)(B, Hkv, Sk, Dh)),
            "v_cache": _w((lambda *s: torch.randn(*s, dtype=torch.bfloat16) * 1.6)(B, Hkv, Sk, Dh)),
            "wq": _w((lambda *s: torch.randn(*s, dtype=torch.bfloat16) * 3.2)(D, Hq * Dh) * (D ** -0.5)),
            "wo": _w((lambda *s: torch.randn(*s, dtype=torch.bfloat16) * 1.6)(Hq * Dh, D) * ((Hq * Dh) ** -0.5)),
        }
    _A_in = _A_setup()

    def _B_setup():
        B, S, D, Dff = 1, 1, 640, 1536
        return {
            "x": _w((lambda *s: torch.randn(*s, dtype=torch.bfloat16) * 0.05)(B, S, D)),
            "w1": _w((lambda *s: torch.randn(*s, dtype=torch.bfloat16) * 0.05)(D, Dff)),
            "w2": _w((lambda *s: torch.randn(*s, dtype=torch.bfloat16) * 0.05)(Dff, D)),
        }
    _B_in = _B_setup()

    return {
        "A_x": _A_in["x"],
        "A_k_cache": _A_in["k_cache"],
        "A_v_cache": _A_in["v_cache"],
        "A_wq": _A_in["wq"],
        "A_wo": _A_in["wo"],
        "B_x": _B_in["x"],
        "B_w1": _B_in["w1"],
        "B_w2": _B_in["w2"],
    }

def reference(A_x, A_k_cache, A_v_cache, A_wq, A_wo, B_x, B_w1, B_w2):
    def _A_ref(x, k_cache, v_cache, wq, wo):
        B, Sq, D = x.shape
        Hq, Dh = 32, 192
        Hkv, Sk = k_cache.shape[1], k_cache.shape[2]
        W = min(4096, max(256, Sk // 4))
        rep = Hq // Hkv
        q = (lambda x, *d: x.permute(*d))((x @ wq).reshape(B, Sq, Hq, Dh), 0, 2, 1, 3)
        k = (lambda x, n, axis: torch.repeat_interleave(x, n, dim=axis))(k_cache[:, :, Sk - W:, :], rep, axis=1)
        v = (lambda x, n, axis: torch.repeat_interleave(x, n, dim=axis))(v_cache[:, :, Sk - W:, :], rep, axis=1)
        scores = torch.einsum("bhqd,bhkd->bhqk", q, k) * (Dh ** -0.5)
        p = _softmax(scores, axis=-1)
        o = torch.einsum("bhqk,bhkd->bhqd", p, v)
        return (lambda x, *d: x.permute(*d))(o, 0, 2, 1, 3).reshape(B, Sq, Hq * Dh) @ wo

    def _B_ref(x, w1, w2):
        h = torch.einsum("bsd,df->bsf", x, w1)
        zero = torch.zeros_like(h)
        h = torch.maximum(h, zero)
        return torch.einsum("bsf,fd->bsd", h, w2)

    x = A_x
    xn = _layernorm(x, axis=-1)
    return x + _A_ref(xn, A_k_cache, A_v_cache, A_wq, A_wo) + _B_ref(xn, B_w1, B_w2)
```

```asm
; @launch grid=(256,1,1) block=(1024,1,1) lds=44032
.amdgcn_target "amdgcn-amd-amdhsa--gfx950"
.text
.globl parallel_sum__sliding_block_cached__dense_activation_relu__decode_kernel
.p2align 8
.type parallel_sum__sliding_block_cached__dense_activation_relu__decode_kernel,@function
parallel_sum__sliding_block_cached__dense_activation_relu__decode_kernel:
    s_cmp_ge_u32 s2, 256
    s_cbranch_scc1 L_end
    s_load_dwordx16 s[64:79], s[0:1], 0
    s_load_dwordx4 s[80:83], s[0:1], 64
    s_load_dwordx2 s[84:85], s[0:1], 80
    s_memrealtime s[50:51]
    v_lshrrev_b32 v4, 6, v0
    v_and_b32 v1, 63, v0
    v_readfirstlane_b32 s46, v4
    s_and_b32 s47, s2, 7
    s_lshr_b32 s48, s2, 3
    s_and_b32 s48, s48, 3
    s_lshl_b32 s44, s47, 2
    s_add_u32 s44, s44, s48
    s_lshr_b32 s45, s2, 5
    v_lshrrev_b32 v4, 3, v1
    v_and_b32 v5, 7, v1
    v_lshlrev_b32 v6, 4, v5
    v_mul_u32_u24 v2, 384, v4
    v_add_u32 v2, v2, v6
    v_mul_u32_u24 v3, 12288, v4
    v_add_u32 v3, v3, v6
    v_mul_u32_u24 v7, 3072, v4
    v_add_u32 v7, v7, v6
    v_mov_b32 v8, 1073741824
    v_cmp_gt_u32 vcc, 6, v5
    s_nop 1
    v_cndmask_b32 v7, v8, v7, vcc
    v_lshlrev_b32 v9, 2, v1
    v_lshlrev_b32 v10, 1, v4
    s_waitcnt lgkmcnt(0)
    s_mov_b32 s4, s64
    s_and_b32 s5, s65, 0xffff
    s_mov_b32 s6, 1280
    s_mov_b32 s7, 0x00020000
    s_mov_b32 s8, s66
    s_and_b32 s9, s67, 0xffff
    s_mov_b32 s10, 402653184
    s_mov_b32 s11, 0x00020000
    s_mov_b32 s12, s68
    s_and_b32 s13, s69, 0xffff
    s_mov_b32 s14, 402653184
    s_mov_b32 s15, 0x00020000
    s_mov_b32 s16, s70
    s_and_b32 s17, s71, 0xffff
    s_mov_b32 s18, 7864320
    s_mov_b32 s19, 0x00020000
    s_mov_b32 s20, s72
    s_and_b32 s21, s73, 0xffff
    s_mov_b32 s22, 7864320
    s_mov_b32 s23, 0x00020000
    s_mov_b32 s24, s76
    s_and_b32 s25, s77, 0xffff
    s_mov_b32 s26, 1966080
    s_mov_b32 s27, 0x00020000
    s_mov_b32 s28, s78
    s_and_b32 s29, s79, 0xffff
    s_mov_b32 s30, 1966080
    s_mov_b32 s31, 0x00020000
    s_mov_b32 s32, s80
    s_and_b32 s33, s81, 0xffff
    s_mov_b32 s34, 1280
    s_mov_b32 s35, 0x00020000
    s_mov_b32 s36, s82
    s_and_b32 s37, s83, 0xffff
    s_mov_b32 s38, 256
    s_mov_b32 s39, 0x00020000
    s_mov_b32 s40, s84
    s_and_b32 s41, s85, 0xffff
    s_mov_b32 s42, 2097152
    s_mov_b32 s43, 0x00020000
    s_or_b32 s50, s50, 1
    s_mul_i32 s47, s44, 12582912
    s_mul_i32 s48, s45, 196608
    s_add_u32 s47, s47, s48
    s_mul_i32 s48, s46, 12288
    s_add_u32 s47, s47, s48
    s_add_u32 s86, s47, 11010048
    s_add_u32 s87, s86, 3072
    s_add_u32 s88, s86, 6144
    s_add_u32 s89, s86, 9216
    s_mul_i32 s47, s45, 983040
    s_mul_i32 s48, s46, 98304
    s_add_u32 s47, s47, s48
    s_mul_i32 s48, s44, 384
    s_add_u32 s90, s47, s48
    s_add_u32 s91, s90, 393216
    s_add_u32 s92, s90, 786432
    s_mul_i32 s47, s45, 245760
    s_mul_i32 s48, s46, 24576
    s_add_u32 s47, s47, s48
    s_mul_i32 s48, s44, 96
    s_add_u32 s93, s47, s48
    s_add_u32 s94, s93, 98304
    s_add_u32 s95, s93, 196608
    s_cmp_lt_u32 s46, 2
    s_cselect_b32 s92, s92, 1073741824
    s_cselect_b32 s95, s95, 1073741824
    s_mul_i32 s47, s45, 160
    s_lshl_b32 s48, s46, 4
    s_add_u32 s97, s47, s48
    s_or_b32 s47, s2, s46
    s_cmp_lg_u32 s47, 0
    s_cbranch_scc1 L_nononce
    v_mov_b32 v116, s50
    v_mov_b32 v117, s51
    v_mov_b32 v120, 0
    s_mov_b64 exec, 1
    buffer_store_dwordx2 v[116:117], v120, s[36:39], 0 offen sc1
    s_mov_b64 exec, -1
L_nononce:
    v_and_b32 v4, 7, v1
    v_lshlrev_b32 v4, 5, v4
    v_lshrrev_b32 v5, 5, v1
    v_lshlrev_b32 v5, 4, v5
    v_add_u32 v4, v4, v5
    v_bfe_u32 v5, v1, 4, 1
    v_lshlrev_b32 v5, 3, v5
    v_add_u32 v4, v4, v5
    s_lshl_b32 s47, s46, 10
    v_add_u32 v6, s47, v4
    v_mov_b32 v26, 0
    v_mov_b32 v27, 0
    v_mov_b32 v24, 0
    v_mov_b32 v25, 0
    v_mov_b32 v4, 26624
    ds_write_b128 v4, v[24:27]
    ds_write_b128 v4, v[24:27] offset:16
    s_cmp_lt_u32 s46, 4
    s_cbranch_scc1 L_qpart
    s_waitcnt lgkmcnt(0)
    s_barrier
    buffer_load_dwordx4 v[32:35], v2, s[8:11], s86 offen offset:0 nt
    buffer_load_dwordx4 v[36:39], v2, s[8:11], s86 offen offset:128 nt
    buffer_load_dwordx4 v[40:43], v2, s[8:11], s86 offen offset:256 nt
    buffer_load_dwordx4 v[44:47], v2, s[8:11], s87 offen offset:0 nt
    buffer_load_dwordx4 v[48:51], v2, s[8:11], s87 offen offset:128 nt
    buffer_load_dwordx4 v[52:55], v2, s[8:11], s87 offen offset:256 nt
    s_mov_b32 s61, 2
    s_cmp_gt_u32 s46, 7
    s_cselect_b32 s61, 1, s61
    s_branch L_k01_done
L_qpart:
    buffer_load_dword v64, v9, s[4:7], 0 offen offset:0
    buffer_load_dword v65, v9, s[4:7], 0 offen offset:256
    buffer_load_dword v66, v9, s[4:7], 0 offen offset:512
    buffer_load_dword v67, v9, s[4:7], 0 offen offset:768
    buffer_load_dword v68, v9, s[4:7], 0 offen offset:1024
    buffer_load_ushort v69, v10, s[4:7], s97 offen offset:0
    buffer_load_ushort v70, v10, s[4:7], s97 offen offset:64
    buffer_load_ushort v71, v10, s[4:7], s97 offen offset:128
    buffer_load_dwordx4 v[80:83], v3, s[16:19], s90 offen offset:0
    buffer_load_dwordx4 v[84:87], v3, s[16:19], s90 offen offset:128
    buffer_load_dwordx4 v[88:91], v3, s[16:19], s90 offen offset:256
    buffer_load_dwordx4 v[116:119], v7, s[24:27], s93 offen
    buffer_load_dwordx4 v[92:95], v3, s[16:19], s91 offen offset:0
    buffer_load_dwordx4 v[96:99], v3, s[16:19], s91 offen offset:128
    buffer_load_dwordx4 v[100:103], v3, s[16:19], s91 offen offset:256
    buffer_load_dwordx4 v[120:123], v7, s[24:27], s94 offen
    buffer_load_dwordx4 v[104:107], v3, s[16:19], s92 offen offset:0
    buffer_load_dwordx4 v[108:111], v3, s[16:19], s92 offen offset:128
    buffer_load_dwordx4 v[112:115], v3, s[16:19], s92 offen offset:256
    buffer_load_dwordx4 v[124:127], v7, s[24:27], s95 offen
    s_waitcnt lgkmcnt(0)
    s_barrier
    s_waitcnt vmcnt(12)
    v_lshlrev_b32 v32, 16, v64
    v_and_b32 v37, 0xffff0000, v64
    v_lshlrev_b32 v33, 16, v65
    v_and_b32 v38, 0xffff0000, v65
    v_lshlrev_b32 v34, 16, v66
    v_and_b32 v39, 0xffff0000, v66
    v_lshlrev_b32 v35, 16, v67
    v_and_b32 v40, 0xffff0000, v67
    v_lshlrev_b32 v36, 16, v68
    v_and_b32 v41, 0xffff0000, v68
    v_add_f32 v4, v32, v33
    v_add_f32 v4, v4, v34
    v_add_f32 v4, v4, v35
    v_add_f32 v4, v4, v36
    v_add_f32 v4, v4, v37
    v_add_f32 v4, v4, v38
    v_add_f32 v4, v4, v39
    v_add_f32 v4, v4, v40
    v_add_f32 v4, v4, v41
    s_nop 1
    v_add_f32_dpp v4, v4, v4 quad_perm:[1,0,3,2] row_mask:0xf bank_mask:0xf
    s_nop 1
    v_add_f32_dpp v4, v4, v4 quad_perm:[2,3,0,1] row_mask:0xf bank_mask:0xf
    s_nop 1
    v_add_f32_dpp v4, v4, v4 row_half_mirror row_mask:0xf bank_mask:0xf
    s_nop 1
    v_add_f32_dpp v4, v4, v4 row_ror:8 row_mask:0xf bank_mask:0xf
    s_nop 1
    v_mov_b32 v5, v4
    s_nop 1
    v_permlane16_swap_b32 v4, v5
    s_nop 0
    v_add_f32 v4, v4, v5
    s_nop 1
    v_mov_b32 v5, v4
    s_nop 1
    v_permlane32_swap_b32 v4, v5
    s_nop 0
    v_add_f32 v4, v4, v5
    v_mul_f32 v4, 0x3acccccd, v4
    v_sub_f32 v32, v32, v4
    v_sub_f32 v33, v33, v4
    v_sub_f32 v34, v34, v4
    v_sub_f32 v35, v35, v4
    v_sub_f32 v36, v36, v4
    v_sub_f32 v37, v37, v4
    v_sub_f32 v38, v38, v4
    v_sub_f32 v39, v39, v4
    v_sub_f32 v40, v40, v4
    v_sub_f32 v41, v41, v4
    v_mul_f32 v12, v32, v32
    v_fmac_f32 v12, v33, v33
    v_fmac_f32 v12, v34, v34
    v_fmac_f32 v12, v35, v35
    v_fmac_f32 v12, v36, v36
    v_fmac_f32 v12, v37, v37
    v_fmac_f32 v12, v38, v38
    v_fmac_f32 v12, v39, v39
    v_fmac_f32 v12, v40, v40
    v_fmac_f32 v12, v41, v41
    s_nop 1
    v_add_f32_dpp v12, v12, v12 quad_perm:[1,0,3,2] row_mask:0xf bank_mask:0xf
    s_nop 1
    v_add_f32_dpp v12, v12, v12 quad_perm:[2,3,0,1] row_mask:0xf bank_mask:0xf
    s_nop 1
    v_add_f32_dpp v12, v12, v12 row_half_mirror row_mask:0xf bank_mask:0xf
    s_nop 1
    v_add_f32_dpp v12, v12, v12 row_ror:8 row_mask:0xf bank_mask:0xf
    s_nop 1
    v_mov_b32 v5, v12
    s_nop 1
    v_permlane16_swap_b32 v12, v5
    s_nop 0
    v_add_f32 v12, v12, v5
    s_nop 1
    v_mov_b32 v5, v12
    s_nop 1
    v_permlane32_swap_b32 v12, v5
    s_nop 0
    v_add_f32 v12, v12, v5
    v_mul_f32 v12, 0x3acccccd, v12
    v_cvt_pk_bf16_f32 v4, v4, v4
    v_and_b32 v4, 0xffff0000, v4
    v_cvt_pk_bf16_f32 v12, v12, v12
    v_and_b32 v12, 0xffff0000, v12
    v_add_f32 v12, 0x3727c5ac, v12
    v_cvt_pk_bf16_f32 v12, v12, v12
    v_and_b32 v12, 0xffff0000, v12
    v_sqrt_f32 v12, v12
    s_nop 0
    v_cvt_pk_bf16_f32 v12, v12, v12
    v_and_b32 v12, 0xffff0000, v12
    v_rcp_f32 v5, v12
    s_nop 0
    v_lshlrev_b32 v69, 16, v69
    v_sub_f32 v69, v69, v4
    v_cvt_pk_bf16_f32 v69, v69, v69
    v_and_b32 v69, 0xffff0000, v69
    v_mul_f32 v32, v69, v5
    v_fma_f32 v33, -v32, v12, v69
    v_fma_f32 v32, v33, v5, v32
    v_cvt_pk_bf16_f32 v16, v32, 0
    v_cvt_pk_bf16_f32 v17, 0, v32
    v_lshlrev_b32 v70, 16, v70
    v_sub_f32 v70, v70, v4
    v_cvt_pk_bf16_f32 v70, v70, v70
    v_and_b32 v70, 0xffff0000, v70
    v_mul_f32 v32, v70, v5
    v_fma_f32 v33, -v32, v12, v70
    v_fma_f32 v32, v33, v5, v32
    v_cvt_pk_bf16_f32 v18, v32, 0
    v_cvt_pk_bf16_f32 v19, 0, v32
    v_lshlrev_b32 v71, 16, v71
    v_sub_f32 v71, v71, v4
    v_cvt_pk_bf16_f32 v71, v71, v71
    v_and_b32 v71, 0xffff0000, v71
    v_mul_f32 v32, v71, v5
    v_fma_f32 v33, -v32, v12, v71
    v_fma_f32 v32, v33, v5, v32
    v_cvt_pk_bf16_f32 v20, v32, 0
    v_cvt_pk_bf16_f32 v21, 0, v32
    buffer_load_dwordx2 v[24:25], v26, s[36:39], 0 offen sc1
    s_waitcnt vmcnt(9)
    v_dot2_f32_bf16 v32, v80, v16, 0
    v_dot2_f32_bf16 v33, v80, v17, 0
    v_dot2_f32_bf16 v34, v81, v16, 0
    v_dot2_f32_bf16 v35, v81, v17, 0
    v_dot2_f32_bf16 v36, v82, v16, 0
    v_dot2_f32_bf16 v37, v82, v17, 0
    v_dot2_f32_bf16 v38, v83, v16, 0
    v_dot2_f32_bf16 v39, v83, v17, 0
    v_dot2_f32_bf16 v40, v84, v16, 0
    v_dot2_f32_bf16 v41, v84, v17, 0
    v_dot2_f32_bf16 v42, v85, v16, 0
    v_dot2_f32_bf16 v43, v85, v17, 0
    v_dot2_f32_bf16 v44, v86, v16, 0
    v_dot2_f32_bf16 v45, v86, v17, 0
    v_dot2_f32_bf16 v46, v87, v16, 0
    v_dot2_f32_bf16 v47, v87, v17, 0
    v_dot2_f32_bf16 v48, v88, v16, 0
    v_dot2_f32_bf16 v49, v88, v17, 0
    v_dot2_f32_bf16 v50, v89, v16, 0
    v_dot2_f32_bf16 v51, v89, v17, 0
    v_dot2_f32_bf16 v52, v90, v16, 0
    v_dot2_f32_bf16 v53, v90, v17, 0
    v_dot2_f32_bf16 v54, v91, v16, 0
    v_dot2_f32_bf16 v55, v91, v17, 0
    v_dot2_f32_bf16 v56, v116, v16, 0
    v_dot2_f32_bf16 v57, v116, v17, 0
    v_dot2_f32_bf16 v58, v117, v16, 0
    v_dot2_f32_bf16 v59, v117, v17, 0
    v_dot2_f32_bf16 v60, v118, v16, 0
    v_dot2_f32_bf16 v61, v118, v17, 0
    v_dot2_f32_bf16 v62, v119, v16, 0
    v_dot2_f32_bf16 v63, v119, v17, 0
    s_waitcnt vmcnt(5)
    v_dot2_f32_bf16 v32, v92, v18, v32
    v_dot2_f32_bf16 v33, v92, v19, v33
    v_dot2_f32_bf16 v34, v93, v18, v34
    v_dot2_f32_bf16 v35, v93, v19, v35
    v_dot2_f32_bf16 v36, v94, v18, v36
    v_dot2_f32_bf16 v37, v94, v19, v37
    v_dot2_f32_bf16 v38, v95, v18, v38
    v_dot2_f32_bf16 v39, v95, v19, v39
    v_dot2_f32_bf16 v40, v96, v18, v40
    v_dot2_f32_bf16 v41, v96, v19, v41
    v_dot2_f32_bf16 v42, v97, v18, v42
    v_dot2_f32_bf16 v43, v97, v19, v43
    v_dot2_f32_bf16 v44, v98, v18, v44
    v_dot2_f32_bf16 v45, v98, v19, v45
    v_dot2_f32_bf16 v46, v99, v18, v46
    v_dot2_f32_bf16 v47, v99, v19, v47
    v_dot2_f32_bf16 v48, v100, v18, v48
    v_dot2_f32_bf16 v49, v100, v19, v49
    v_dot2_f32_bf16 v50, v101, v18, v50
    v_dot2_f32_bf16 v51, v101, v19, v51
    v_dot2_f32_bf16 v52, v102, v18, v52
    v_dot2_f32_bf16 v53, v102, v19, v53
    v_dot2_f32_bf16 v54, v103, v18, v54
    v_dot2_f32_bf16 v55, v103, v19, v55
    v_dot2_f32_bf16 v56, v120, v18, v56
    v_dot2_f32_bf16 v57, v120, v19, v57
    v_dot2_f32_bf16 v58, v121, v18, v58
    v_dot2_f32_bf16 v59, v121, v19, v59
    v_dot2_f32_bf16 v60, v122, v18, v60
    v_dot2_f32_bf16 v61, v122, v19, v61
    v_dot2_f32_bf16 v62, v123, v18, v62
    v_dot2_f32_bf16 v63, v123, v19, v63
    s_waitcnt vmcnt(1)
    v_dot2_f32_bf16 v32, v104, v20, v32
    v_dot2_f32_bf16 v33, v104, v21, v33
    v_dot2_f32_bf16 v34, v105, v20, v34
    v_dot2_f32_bf16 v35, v105, v21, v35
    v_dot2_f32_bf16 v36, v106, v20, v36
    v_dot2_f32_bf16 v37, v106, v21, v37
    v_dot2_f32_bf16 v38, v107, v20, v38
    v_dot2_f32_bf16 v39, v107, v21, v39
    v_dot2_f32_bf16 v40, v108, v20, v40
    v_dot2_f32_bf16 v41, v108, v21, v41
    v_dot2_f32_bf16 v42, v109, v20, v42
    v_dot2_f32_bf16 v43, v109, v21, v43
    v_dot2_f32_bf16 v44, v110, v20, v44
    v_dot2_f32_bf16 v45, v110, v21, v45
    v_dot2_f32_bf16 v46, v111, v20, v46
    v_dot2_f32_bf16 v47, v111, v21, v47
    v_dot2_f32_bf16 v48, v112, v20, v48
    v_dot2_f32_bf16 v49, v112, v21, v49
    v_dot2_f32_bf16 v50, v113, v20, v50
    v_dot2_f32_bf16 v51, v113, v21, v51
    v_dot2_f32_bf16 v52, v114, v20, v52
    v_dot2_f32_bf16 v53, v114, v21, v53
    v_dot2_f32_bf16 v54, v115, v20, v54
    v_dot2_f32_bf16 v55, v115, v21, v55
    v_dot2_f32_bf16 v56, v124, v20, v56
    v_dot2_f32_bf16 v57, v124, v21, v57
    v_dot2_f32_bf16 v58, v125, v20, v58
    v_dot2_f32_bf16 v59, v125, v21, v59
    v_dot2_f32_bf16 v60, v126, v20, v60
    v_dot2_f32_bf16 v61, v126, v21, v61
    v_dot2_f32_bf16 v62, v127, v20, v62
    v_dot2_f32_bf16 v63, v127, v21, v63
    s_nop 2
    v_permlane32_swap_b32 v32, v36
    v_permlane32_swap_b32 v33, v37
    v_permlane32_swap_b32 v34, v38
    v_permlane32_swap_b32 v35, v39
    v_permlane32_swap_b32 v40, v44
    v_permlane32_swap_b32 v41, v45
    v_permlane32_swap_b32 v42, v46
    v_permlane32_swap_b32 v43, v47
    v_permlane32_swap_b32 v48, v52
    v_permlane32_swap_b32 v49, v53
    v_permlane32_swap_b32 v50, v54
    v_permlane32_swap_b32 v51, v55
    v_permlane32_swap_b32 v56, v60
    v_permlane32_swap_b32 v57, v61
    v_permlane32_swap_b32 v58, v62
    v_permlane32_swap_b32 v59, v63
    s_nop 0
    v_add_f32 v32, v32, v36
    v_add_f32 v33, v33, v37
    v_add_f32 v34, v34, v38
    v_add_f32 v35, v35, v39
    v_add_f32 v40, v40, v44
    v_add_f32 v41, v41, v45
    v_add_f32 v42, v42, v46
    v_add_f32 v43, v43, v47
    v_add_f32 v48, v48, v52
    v_add_f32 v49, v49, v53
    v_add_f32 v50, v50, v54
    v_add_f32 v51, v51, v55
    v_add_f32 v56, v56, v60
    v_add_f32 v57, v57, v61
    v_add_f32 v58, v58, v62
    v_add_f32 v59, v59, v63
    s_nop 1
    v_permlane16_swap_b32 v32, v34
    v_permlane16_swap_b32 v33, v35
    v_permlane16_swap_b32 v40, v42
    v_permlane16_swap_b32 v41, v43
    v_permlane16_swap_b32 v48, v50
    v_permlane16_swap_b32 v49, v51
    v_permlane16_swap_b32 v56, v58
    v_permlane16_swap_b32 v57, v59
    s_nop 0
    v_add_f32 v32, v32, v34
    v_add_f32 v33, v33, v35
    v_add_f32 v40, v40, v42
    v_add_f32 v41, v41, v43
    v_add_f32 v48, v48, v50
    v_add_f32 v49, v49, v51
    v_add_f32 v56, v56, v58
    v_add_f32 v57, v57, v59
    s_nop 1
    v_add_f32_dpp v32, v32, v32 row_ror:8 row_mask:0xf bank_mask:0xf
    v_add_f32_dpp v33, v33, v33 row_ror:8 row_mask:0xf bank_mask:0xf
    v_add_f32_dpp v40, v40, v40 row_ror:8 row_mask:0xf bank_mask:0xf
    v_add_f32_dpp v41, v41, v41 row_ror:8 row_mask:0xf bank_mask:0xf
    v_add_f32_dpp v48, v48, v48 row_ror:8 row_mask:0xf bank_mask:0xf
    v_add_f32_dpp v49, v49, v49 row_ror:8 row_mask:0xf bank_mask:0xf
    v_add_f32_dpp v56, v56, v56 row_ror:8 row_mask:0xf bank_mask:0xf
    v_add_f32_dpp v57, v57, v57 row_ror:8 row_mask:0xf bank_mask:0xf
    ds_write_b64 v6, v[32:33] offset:0
    ds_write_b64 v6, v[40:41] offset:256
    ds_write_b64 v6, v[48:49] offset:512
    ds_write_b64 v6, v[56:57] offset:768
    s_waitcnt lgkmcnt(0)
    s_cmp_eq_u32 s46, 0
    s_cbranch_scc1 L_xchg
    s_lshl_b32 s47, s46, 2
    v_mov_b32 v4, s47
    v_mov_b32 v5, 1
    ds_write_b32 v4, v5 offset:26624
    s_branch L_xchg_done
L_xchg:
    v_mov_b32 v4, 26624
    s_mov_b32 s60, 0
L_fl_loop:
    ds_read_b128 v[32:35], v4
    s_waitcnt lgkmcnt(0)
    v_and_b32 v33, v33, v34
    v_and_b32 v33, v33, v35
    s_nop 0
    v_readfirstlane_b32 s47, v33
    s_nop 1
    s_cmp_eq_u32 s47, 1
    s_cbranch_scc1 L_fl_done
    s_add_u32 s60, s60, 1
    s_cmp_lt_u32 s60, 4000000
    s_cbranch_scc1 L_fl_loop
L_fl_done:
    v_lshlrev_b32 v4, 3, v1
    ds_read_b64 v[96:97], v4 offset:0
    ds_read_b64 v[104:105], v4 offset:512
    ds_read_b64 v[98:99], v4 offset:1024
    ds_read_b64 v[106:107], v4 offset:1536
    ds_read_b64 v[100:101], v4 offset:2048
    ds_read_b64 v[108:109], v4 offset:2560
    ds_read_b64 v[102:103], v4 offset:3072
    ds_read_b64 v[110:111], v4 offset:3584
    s_mov_b32 s60, 0
    s_waitcnt vmcnt(0)
L_nonce_loop:
    v_readfirstlane_b32 s52, v24
    v_readfirstlane_b32 s53, v25
    s_nop 1
    s_or_b32 s47, s52, s53
    s_cmp_lg_u32 s47, 0
    s_cbranch_scc1 L_nonce_ok
    s_add_u32 s60, s60, 1
    s_cmp_lt_u32 s60, 400000
    s_cbranch_scc0 L_nonce_ok
    buffer_load_dwordx2 v[24:25], v26, s[36:39], 0 offen sc1
    s_waitcnt vmcnt(0)
    s_branch L_nonce_loop
L_nonce_ok:
    s_waitcnt lgkmcnt(0)
    v_add_f32 v96, v96, v98
    v_add_f32 v97, v97, v99
    v_add_f32 v104, v104, v106
    v_add_f32 v105, v105, v107
    v_add_f32 v96, v96, v100
    v_add_f32 v97, v97, v101
    v_add_f32 v104, v104, v108
    v_add_f32 v105, v105, v109
    v_add_f32 v96, v96, v102
    v_add_f32 v97, v97, v103
    v_add_f32 v104, v104, v110
    v_add_f32 v105, v105, v111
    v_mov_b32 v98, s52
    v_mov_b32 v99, s53
    v_mov_b32 v106, s52
    v_mov_b32 v107, s53
    s_lshl_b32 s47, s44, 3
    s_add_u32 s47, s47, s45
    s_lshl_b32 s48, s47, 11
    s_add_u32 s48, s48, 524288
    v_lshlrev_b32 v4, 4, v1
    v_add_u32 v5, s48, v4
    buffer_store_dwordx4 v[96:99], v5, s[40:43], 0 offen sc1
    buffer_store_dwordx4 v[104:107], v5, s[40:43], 0 offen offset:1024 sc1
    buffer_load_dwordx4 v[32:35], v2, s[8:11], s86 offen offset:0 nt
    buffer_load_dwordx4 v[36:39], v2, s[8:11], s86 offen offset:128 nt
    buffer_load_dwordx4 v[40:43], v2, s[8:11], s86 offen offset:256 nt
    buffer_load_dwordx4 v[44:47], v2, s[8:11], s87 offen offset:0 nt
    buffer_load_dwordx4 v[48:51], v2, s[8:11], s87 offen offset:128 nt
    buffer_load_dwordx4 v[52:55], v2, s[8:11], s87 offen offset:256 nt
    buffer_load_dwordx4 v[56:59], v2, s[8:11], s88 offen offset:0 nt
    buffer_load_dwordx4 v[60:63], v2, s[8:11], s88 offen offset:128 nt
    buffer_load_dwordx4 v[64:67], v2, s[8:11], s88 offen offset:256 nt
    buffer_load_dwordx4 v[68:71], v2, s[8:11], s89 offen offset:0 nt
    buffer_load_dwordx4 v[72:75], v2, s[8:11], s89 offen offset:128 nt
    buffer_load_dwordx4 v[76:79], v2, s[8:11], s89 offen offset:256 nt
    s_lshl_b32 s48, s44, 14
    s_add_u32 s48, s48, 524288
    v_add_u32 v5, s48, v4
    v_add_u32 v7, 0x1000, v5
    v_add_u32 v12, 0x2000, v5
    v_add_u32 v13, 0x3000, v5
    v_cmp_gt_u32 vcc, 56, v1
    s_nop 1
    s_mov_b64 s[58:59], vcc
    s_mov_b32 s60, 0
    v_lshlrev_b32 v14, 11, v1
    v_add_u32 v14, s48, v14
    s_mov_b64 exec, 0xff
L_poll0a:
    buffer_load_dwordx4 v[112:115], v14, s[40:43], 0 offen offset:1024 sc1
    s_waitcnt vmcnt(0)
    v_cmp_ne_u32 vcc, s52, v114
    v_cmp_ne_u32 s[56:57], s53, v115
    s_nop 1
    s_or_b64 vcc, vcc, s[56:57]
    s_cmp_eq_u64 vcc, 0
    s_cbranch_scc1 L_poll0a_done
    s_add_u32 s60, s60, 1
    s_cmp_lt_u32 s60, 400000
    s_cbranch_scc0 L_poll0a_done
    s_sleep 2
    s_branch L_poll0a
L_poll0a_done:
    s_mov_b64 exec, -1
L_poll0:
    buffer_load_dwordx4 v[80:83], v5, s[40:43], 0 offen offset:0 sc1
    buffer_load_dwordx4 v[84:87], v5, s[40:43], 0 offen offset:1024 sc1
    buffer_load_dwordx4 v[88:91], v5, s[40:43], 0 offen offset:2048 sc1
    buffer_load_dwordx4 v[92:95], v5, s[40:43], 0 offen offset:3072 sc1
    buffer_load_dwordx4 v[96:99], v7, s[40:43], 0 offen offset:0 sc1
    buffer_load_dwordx4 v[100:103], v7, s[40:43], 0 offen offset:1024 sc1
    buffer_load_dwordx4 v[104:107], v7, s[40:43], 0 offen offset:2048 sc1
    buffer_load_dwordx4 v[108:111], v7, s[40:43], 0 offen offset:3072 sc1
    buffer_load_dwordx4 v[112:115], v12, s[40:43], 0 offen offset:0 sc1
    buffer_load_dwordx4 v[116:119], v12, s[40:43], 0 offen offset:1024 sc1
    buffer_load_dwordx4 v[120:123], v12, s[40:43], 0 offen offset:2048 sc1
    buffer_load_dwordx4 v[124:127], v12, s[40:43], 0 offen offset:3072 sc1
    buffer_load_dwordx4 v[16:19], v13, s[40:43], 0 offen offset:0 sc1
    buffer_load_dwordx4 v[20:23], v13, s[40:43], 0 offen offset:1024 sc1
    buffer_load_dwordx4 v[24:27], v13, s[40:43], 0 offen offset:2048 sc1
    buffer_load_dwordx4 v[28:31], v13, s[40:43], 0 offen offset:3072 sc1
    s_waitcnt vmcnt(0)
    v_xor_b32 v14, s52, v82
    v_xor_b32 v15, s53, v83
    v_or_b32 v14, v14, v15
    v_xor_b32 v15, s52, v90
    v_or_b32 v14, v14, v15
    v_xor_b32 v15, s53, v91
    v_or_b32 v14, v14, v15
    v_xor_b32 v15, s52, v98
    v_or_b32 v14, v14, v15
    v_xor_b32 v15, s53, v99
    v_or_b32 v14, v14, v15
    v_xor_b32 v15, s52, v106
    v_or_b32 v14, v14, v15
    v_xor_b32 v15, s53, v107
    v_or_b32 v14, v14, v15
    v_xor_b32 v15, s52, v114
    v_or_b32 v14, v14, v15
    v_xor_b32 v15, s53, v115
    v_or_b32 v14, v14, v15
    v_xor_b32 v15, s52, v122
    v_or_b32 v14, v14, v15
    v_xor_b32 v15, s53, v123
    v_or_b32 v14, v14, v15
    v_xor_b32 v15, s52, v18
    v_or_b32 v14, v14, v15
    v_xor_b32 v15, s53, v19
    v_or_b32 v14, v14, v15
    v_xor_b32 v15, s52, v26
    v_or_b32 v14, v14, v15
    v_xor_b32 v15, s53, v27
    v_or_b32 v14, v14, v15
    v_xor_b32 v8, s52, v86
    v_xor_b32 v15, s53, v87
    v_or_b32 v8, v8, v15
    v_xor_b32 v15, s52, v94
    v_or_b32 v8, v8, v15
    v_xor_b32 v15, s53, v95
    v_or_b32 v8, v8, v15
    v_xor_b32 v15, s52, v102
    v_or_b32 v8, v8, v15
    v_xor_b32 v15, s53, v103
    v_or_b32 v8, v8, v15
    v_xor_b32 v15, s52, v110
    v_or_b32 v8, v8, v15
    v_xor_b32 v15, s53, v111
    v_or_b32 v8, v8, v15
    v_xor_b32 v15, s52, v118
    v_or_b32 v8, v8, v15
    v_xor_b32 v15, s53, v119
    v_or_b32 v8, v8, v15
    v_xor_b32 v15, s52, v126
    v_or_b32 v8, v8, v15
    v_xor_b32 v15, s53, v127
    v_or_b32 v8, v8, v15
    v_xor_b32 v15, s52, v22
    v_or_b32 v8, v8, v15
    v_xor_b32 v15, s53, v23
    v_or_b32 v8, v8, v15
    v_xor_b32 v15, s52, v30
    v_or_b32 v8, v8, v15
    v_xor_b32 v15, s53, v31
    v_or_b32 v8, v8, v15
    v_cmp_ne_u32 vcc, 0, v8
    v_cmp_ne_u32 s[56:57], 0, v14
    s_nop 1
    s_and_b64 vcc, vcc, s[58:59]
    s_or_b64 vcc, vcc, s[56:57]
    s_cmp_eq_u64 vcc, 0
    s_cbranch_scc1 L_poll0_done
    s_add_u32 s60, s60, 1
    s_cmp_lt_u32 s60, 400000
    s_cbranch_scc0 L_poll0_done
    s_sleep 1
    s_branch L_poll0
L_poll0_done:
    v_add_f32 v80, v80, v88
    v_add_f32 v81, v81, v89
    v_add_f32 v84, v84, v92
    v_add_f32 v85, v85, v93
    v_add_f32 v80, v80, v96
    v_add_f32 v81, v81, v97
    v_add_f32 v84, v84, v100
    v_add_f32 v85, v85, v101
    v_add_f32 v80, v80, v104
    v_add_f32 v81, v81, v105
    v_add_f32 v84, v84, v108
    v_add_f32 v85, v85, v109
    v_add_f32 v80, v80, v112
    v_add_f32 v81, v81, v113
    v_add_f32 v84, v84, v116
    v_add_f32 v85, v85, v117
    v_add_f32 v80, v80, v120
    v_add_f32 v81, v81, v121
    v_add_f32 v84, v84, v124
    v_add_f32 v85, v85, v125
    v_add_f32 v80, v80, v16
    v_add_f32 v81, v81, v17
    v_add_f32 v84, v84, v20
    v_add_f32 v85, v85, v21
    v_add_f32 v80, v80, v24
    v_add_f32 v81, v81, v25
    v_add_f32 v84, v84, v28
    v_add_f32 v85, v85, v29
    v_cvt_pk_bf16_f32 v80, v80, v81
    v_cvt_pk_bf16_f32 v84, v84, v85
    v_lshlrev_b32 v5, 2, v1
    ds_write_b32 v5, v80 offset:24576
    v_cmp_gt_u32 vcc, 32, v1
    s_and_saveexec_b64 s[62:63], vcc
    ds_write_b32 v5, v84 offset:24832
    s_mov_b64 exec, s[62:63]
    v_lshlrev_b32 v86, 16, v84
    v_and_b32 v87, 0xffff0000, v84
    v_max_f32 v86, 0, v86
    v_max_f32 v87, 0, v87
    v_cmp_gt_u32 vcc, 56, v1
    s_nop 1
    v_cndmask_b32 v86, 0, v86, vcc
    v_cndmask_b32 v87, 0, v87, vcc
    v_cmp_lt_u32 vcc, 31, v1
    v_cmp_gt_u32 s[56:57], 58, v1
    s_nop 1
    s_and_b64 vcc, vcc, s[56:57]
    v_lshlrev_b32 v5, 3, v1
    s_and_saveexec_b64 s[62:63], vcc
    ds_write_b64 v5, v[86:87] offset:25600
    s_mov_b64 exec, s[62:63]
    v_mov_b32 v88, s52
    v_mov_b32 v89, s53
    v_mov_b32 v5, 26176
    ds_write_b64 v5, v[88:89]
    s_waitcnt lgkmcnt(0)
    v_mov_b32 v4, 26624
    v_mov_b32 v5, 1
    ds_write_b32 v4, v5
    s_mov_b32 s61, 0
    s_branch L_vissue
L_xchg_done:
    s_mov_b32 s61, 2
    s_cmp_gt_u32 s46, 7
    s_cselect_b32 s61, 1, s61
    buffer_load_dwordx4 v[32:35], v2, s[8:11], s86 offen offset:0 nt
    buffer_load_dwordx4 v[36:39], v2, s[8:11], s86 offen offset:128 nt
    buffer_load_dwordx4 v[40:43], v2, s[8:11], s86 offen offset:256 nt
    buffer_load_dwordx4 v[44:47], v2, s[8:11], s87 offen offset:0 nt
    buffer_load_dwordx4 v[48:51], v2, s[8:11], s87 offen offset:128 nt
    buffer_load_dwordx4 v[52:55], v2, s[8:11], s87 offen offset:256 nt
L_k01_done:
    s_cmp_lt_u32 s61, 1
    s_cbranch_scc1 L_cw0
    s_waitcnt vmcnt(3)
L_cw0:
    buffer_load_dwordx4 v[56:59], v2, s[8:11], s88 offen offset:0 nt
    buffer_load_dwordx4 v[60:63], v2, s[8:11], s88 offen offset:128 nt
    buffer_load_dwordx4 v[64:67], v2, s[8:11], s88 offen offset:256 nt
    s_cmp_lt_u32 s61, 2
    s_cbranch_scc1 L_cw1
    s_waitcnt vmcnt(3)
L_cw1:
    buffer_load_dwordx4 v[68:71], v2, s[8:11], s89 offen offset:0 nt
    buffer_load_dwordx4 v[72:75], v2, s[8:11], s89 offen offset:128 nt
    buffer_load_dwordx4 v[76:79], v2, s[8:11], s89 offen offset:256 nt
    s_cmp_lt_u32 s61, 2
    s_cbranch_scc1 L_cw2
    s_waitcnt vmcnt(3)
L_cw2:
L_vissue:
    buffer_load_dwordx4 v[80:83], v2, s[12:15], s86 offen offset:0 nt
    buffer_load_dwordx4 v[84:87], v2, s[12:15], s86 offen offset:128 nt
    buffer_load_dwordx4 v[88:91], v2, s[12:15], s86 offen offset:256 nt
    s_cmp_lt_u32 s61, 2
    s_cbranch_scc1 L_cw3
    s_waitcnt vmcnt(3)
L_cw3:
    buffer_load_dwordx4 v[92:95], v2, s[12:15], s87 offen offset:0 nt
    buffer_load_dwordx4 v[96:99], v2, s[12:15], s87 offen offset:128 nt
    buffer_load_dwordx4 v[100:103], v2, s[12:15], s87 offen offset:256 nt
    s_cmp_lt_u32 s61, 2
    s_cbranch_scc1 L_cw4
    s_waitcnt vmcnt(3)
L_cw4:
    buffer_load_dwordx4 v[104:107], v2, s[12:15], s88 offen offset:0 nt
    buffer_load_dwordx4 v[108:111], v2, s[12:15], s88 offen offset:128 nt
    buffer_load_dwordx4 v[112:115], v2, s[12:15], s88 offen offset:256 nt
    s_cmp_lt_u32 s61, 2
    s_cbranch_scc1 L_cw5
    s_waitcnt vmcnt(3)
L_cw5:
    buffer_load_dwordx4 v[116:119], v2, s[12:15], s89 offen offset:0 nt
    buffer_load_dwordx4 v[120:123], v2, s[12:15], s89 offen offset:128 nt
    buffer_load_dwordx4 v[124:127], v2, s[12:15], s89 offen offset:256 nt
    v_lshrrev_b32 v4, 4, v1
    v_and_b32 v5, 15, v1
    v_mul_u32_u24 v7, 1280, v4
    v_lshlrev_b32 v15, 4, v5
    v_add_u32 v7, v7, v15
    v_mov_b32 v15, 1073741824
    v_cmp_gt_u32 vcc, 10, v5
    s_nop 1
    v_cndmask_b32 v7, v15, v7, vcc
    v_cmp_gt_u32 vcc, 3, v4
    s_nop 1
    v_cndmask_b32 v15, v15, v7, vcc
    s_mul_i32 s47, s44, 192
    s_mul_i32 s48, s46, 12
    s_add_u32 s47, s47, s48
    s_mul_i32 s47, s47, 1280
    s_mul_i32 s48, s45, 160
    s_add_u32 s54, s47, s48
    s_add_u32 s55, s54, 5120
    s_add_u32 s56, s54, 10240
    s_mul_i32 s47, s44, 48
    s_mul_i32 s49, s46, 3
    s_add_u32 s47, s47, s49
    s_mul_i32 s47, s47, 1280
    s_add_u32 s57, s47, s48
    buffer_load_dwordx4 v[28:31], v15, s[28:31], s57 offen
    v_lshlrev_b32 v3, 5, v5
    v_lshrrev_b32 v15, 5, v1
    v_lshlrev_b32 v15, 4, v15
    v_add_u32 v3, v3, v15
    v_bfe_u32 v15, v1, 4, 1
    v_lshlrev_b32 v15, 3, v15
    v_add_u32 v3, v3, v15
    v_mov_b32 v4, 26624
    s_mov_b32 s60, 0
L_qf_loop:
    ds_read_b32 v5, v4
    s_waitcnt lgkmcnt(0)
    v_readfirstlane_b32 s47, v5
    s_nop 1
    s_cmp_eq_u32 s47, 1
    s_cbranch_scc1 L_qf_done
    s_add_u32 s60, s60, 1
    s_cmp_lt_u32 s60, 4000000
    s_cbranch_scc0 L_qf_done
    s_sleep 2
    s_branch L_qf_loop
L_qf_done:
    v_and_b32 v4, 7, v1
    v_lshlrev_b32 v4, 4, v4
    ds_read_b128 v[16:19], v4 offset:24576
    ds_read_b128 v[20:23], v4 offset:24704
    ds_read_b128 v[24:27], v4 offset:24832
    v_mov_b32 v4, 26176
    ds_read_b64 v[8:9], v4
    s_waitcnt lgkmcnt(0)
    v_readfirstlane_b32 s52, v8
    v_readfirstlane_b32 s53, v9
    s_waitcnt vmcnt(22)
    v_dot2_f32_bf16 v12, v32, v16, 0
    v_dot2_f32_bf16 v13, v33, v17, 0
    v_dot2_f32_bf16 v14, v34, v18, 0
    v_dot2_f32_bf16 v12, v35, v19, v12
    v_dot2_f32_bf16 v13, v36, v20, v13
    v_dot2_f32_bf16 v14, v37, v21, v14
    v_dot2_f32_bf16 v12, v38, v22, v12
    v_dot2_f32_bf16 v13, v39, v23, v13
    v_dot2_f32_bf16 v14, v40, v24, v14
    v_dot2_f32_bf16 v12, v41, v25, v12
    v_dot2_f32_bf16 v13, v42, v26, v13
    v_dot2_f32_bf16 v14, v43, v27, v14
    s_nop 2
    v_add_f32 v12, v12, v13
    v_add_f32 v12, v12, v14
    s_nop 1
    v_add_f32_dpp v12, v12, v12 quad_perm:[1,0,3,2] row_mask:0xf bank_mask:0xf
    s_nop 1
    v_add_f32_dpp v12, v12, v12 quad_perm:[2,3,0,1] row_mask:0xf bank_mask:0xf
    s_nop 1
    v_add_f32_dpp v12, v12, v12 row_half_mirror row_mask:0xf bank_mask:0xf
    v_cvt_pk_bf16_f32 v12, v12, v12
    v_and_b32 v12, 0xffff0000, v12
    v_mul_f32 v12, 0x3d93cd3a, v12
    v_cvt_pk_bf16_f32 v8, v12, v12
    v_and_b32 v8, 0xffff0000, v8
    s_waitcnt vmcnt(19)
    v_dot2_f32_bf16 v12, v44, v16, 0
    v_dot2_f32_bf16 v13, v45, v17, 0
    v_dot2_f32_bf16 v14, v46, v18, 0
    v_dot2_f32_bf16 v12, v47, v19, v12
    v_dot2_f32_bf16 v13, v48, v20, v13
    v_dot2_f32_bf16 v14, v49, v21, v14
    v_dot2_f32_bf16 v12, v50, v22, v12
    v_dot2_f32_bf16 v13, v51, v23, v13
    v_dot2_f32_bf16 v14, v52, v24, v14
    v_dot2_f32_bf16 v12, v53, v25, v12
    v_dot2_f32_bf16 v13, v54, v26, v13
    v_dot2_f32_bf16 v14, v55, v27, v14
    s_nop 2
    v_add_f32 v12, v12, v13
    v_add_f32 v12, v12, v14
    s_nop 1
    v_add_f32_dpp v12, v12, v12 quad_perm:[1,0,3,2] row_mask:0xf bank_mask:0xf
    s_nop 1
    v_add_f32_dpp v12, v12, v12 quad_perm:[2,3,0,1] row_mask:0xf bank_mask:0xf
    s_nop 1
    v_add_f32_dpp v12, v12, v12 row_half_mirror row_mask:0xf bank_mask:0xf
    v_cvt_pk_bf16_f32 v12, v12, v12
    v_and_b32 v12, 0xffff0000, v12
    v_mul_f32 v12, 0x3d93cd3a, v12
    v_cvt_pk_bf16_f32 v9, v12, v12
    v_and_b32 v9, 0xffff0000, v9
    s_waitcnt vmcnt(16)
    v_dot2_f32_bf16 v12, v56, v16, 0
    v_dot2_f32_bf16 v13, v57, v17, 0
    v_dot2_f32_bf16 v14, v58, v18, 0
    v_dot2_f32_bf16 v12, v59, v19, v12
    v_dot2_f32_bf16 v13, v60, v20, v13
    v_dot2_f32_bf16 v14, v61, v21, v14
    v_dot2_f32_bf16 v12, v62, v22, v12
    v_dot2_f32_bf16 v13, v63, v23, v13
    v_dot2_f32_bf16 v14, v64, v24, v14
    v_dot2_f32_bf16 v12, v65, v25, v12
    v_dot2_f32_bf16 v13, v66, v26, v13
    v_dot2_f32_bf16 v14, v67, v27, v14
    s_nop 2
    v_add_f32 v12, v12, v13
    v_add_f32 v12, v12, v14
    s_nop 1
    v_add_f32_dpp v12, v12, v12 quad_perm:[1,0,3,2] row_mask:0xf bank_mask:0xf
    s_nop 1
    v_add_f32_dpp v12, v12, v12 quad_perm:[2,3,0,1] row_mask:0xf bank_mask:0xf
    s_nop 1
    v_add_f32_dpp v12, v12, v12 row_half_mirror row_mask:0xf bank_mask:0xf
    v_cvt_pk_bf16_f32 v12, v12, v12
    v_and_b32 v12, 0xffff0000, v12
    v_mul_f32 v12, 0x3d93cd3a, v12
    v_cvt_pk_bf16_f32 v10, v12, v12
    v_and_b32 v10, 0xffff0000, v10
    s_waitcnt vmcnt(13)
    v_dot2_f32_bf16 v12, v68, v16, 0
    v_dot2_f32_bf16 v13, v69, v17, 0
    v_dot2_f32_bf16 v14, v70, v18, 0
    v_dot2_f32_bf16 v12, v71, v19, v12
    v_dot2_f32_bf16 v13, v72, v20, v13
    v_dot2_f32_bf16 v14, v73, v21, v14
    v_dot2_f32_bf16 v12, v74, v22, v12
    v_dot2_f32_bf16 v13, v75, v23, v13
    v_dot2_f32_bf16 v14, v76, v24, v14
    v_dot2_f32_bf16 v12, v77, v25, v12
    v_dot2_f32_bf16 v13, v78, v26, v13
    v_dot2_f32_bf16 v14, v79, v27, v14
    s_nop 2
    v_add_f32 v12, v12, v13
    v_add_f32 v12, v12, v14
    s_nop 1
    v_add_f32_dpp v12, v12, v12 quad_perm:[1,0,3,2] row_mask:0xf bank_mask:0xf
    s_nop 1
    v_add_f32_dpp v12, v12, v12 quad_perm:[2,3,0,1] row_mask:0xf bank_mask:0xf
    s_nop 1
    v_add_f32_dpp v12, v12, v12 row_half_mirror row_mask:0xf bank_mask:0xf
    v_cvt_pk_bf16_f32 v12, v12, v12
    v_and_b32 v12, 0xffff0000, v12
    v_mul_f32 v12, 0x3d93cd3a, v12
    v_cvt_pk_bf16_f32 v11, v12, v12
    v_and_b32 v11, 0xffff0000, v11
    s_mul_i32 s47, s46, 12
    v_lshrrev_b32 v4, 4, v1
    v_lshlrev_b32 v15, 2, v4
    v_add_u32 v15, s47, v15
    ds_read_b32 v25, v15 offset:25856
    s_cmp_lt_u32 s46, 12
    s_cbranch_scc1 L_wo_defer
    v_mov_b32 v15, 26640
    v_mov_b32 v14, 1
    s_mov_b64 exec, 1
    ds_add_u32 v15, v14
    s_mov_b64 exec, -1
L_wo_defer:
    v_max_f32 v12, v8, v9
    v_max3_f32 v12, v12, v10, v11
    s_nop 1
    v_max_f32_dpp v12, v12, v12 row_ror:8 row_mask:0xf bank_mask:0xf
    s_nop 1
    v_mov_b32 v13, v12
    s_nop 1
    v_permlane16_swap_b32 v12, v13
    s_nop 0
    v_max_f32 v12, v12, v13
    s_nop 1
    v_mov_b32 v13, v12
    s_nop 1
    v_permlane32_swap_b32 v12, v13
    s_nop 0
    v_max_f32 v12, v12, v13
    v_sub_f32 v8, v8, v12
    v_mul_f32 v8, 0x3fb8aa3b, v8
    v_exp_f32 v8, v8
    v_sub_f32 v9, v9, v12
    v_mul_f32 v9, 0x3fb8aa3b, v9
    v_exp_f32 v9, v9
    v_sub_f32 v10, v10, v12
    v_mul_f32 v10, 0x3fb8aa3b, v10
    v_exp_f32 v10, v10
    v_sub_f32 v11, v11, v12
    v_mul_f32 v11, 0x3fb8aa3b, v11
    v_exp_f32 v11, v11
    s_nop 0
    v_cvt_pk_bf16_f32 v16, v8, 0
    v_cvt_pk_bf16_f32 v17, 0, v8
    v_cvt_pk_bf16_f32 v18, v9, 0
    v_cvt_pk_bf16_f32 v19, 0, v9
    v_cvt_pk_bf16_f32 v20, v10, 0
    v_cvt_pk_bf16_f32 v21, 0, v10
    v_cvt_pk_bf16_f32 v22, v11, 0
    v_cvt_pk_bf16_f32 v23, 0, v11
    v_add_f32 v13, v17, v19
    v_add_f32 v13, v13, v21
    v_add_f32 v13, v13, v23
    s_nop 1
    v_add_f32_dpp v13, v13, v13 row_ror:8 row_mask:0xf bank_mask:0xf
    s_nop 1
    v_mov_b32 v14, v13
    s_nop 1
    v_permlane16_swap_b32 v13, v14
    s_nop 0
    v_add_f32 v13, v13, v14
    s_nop 1
    v_mov_b32 v14, v13
    s_nop 1
    v_permlane32_swap_b32 v13, v14
    s_nop 0
    v_add_f32 v13, v13, v14
    s_waitcnt vmcnt(10)
    v_dot2_f32_bf16 v32, v80, v16, 0
    v_dot2_f32_bf16 v33, v80, v17, 0
    v_dot2_f32_bf16 v34, v81, v16, 0
    v_dot2_f32_bf16 v35, v81, v17, 0
    v_dot2_f32_bf16 v36, v82, v16, 0
    v_dot2_f32_bf16 v37, v82, v17, 0
    v_dot2_f32_bf16 v38, v83, v16, 0
    v_dot2_f32_bf16 v39, v83, v17, 0
    v_dot2_f32_bf16 v40, v84, v16, 0
    v_dot2_f32_bf16 v41, v84, v17, 0
    v_dot2_f32_bf16 v42, v85, v16, 0
    v_dot2_f32_bf16 v43, v85, v17, 0
    v_dot2_f32_bf16 v44, v86, v16, 0
    v_dot2_f32_bf16 v45, v86, v17, 0
    v_dot2_f32_bf16 v46, v87, v16, 0
    v_dot2_f32_bf16 v47, v87, v17, 0
    v_dot2_f32_bf16 v48, v88, v16, 0
    v_dot2_f32_bf16 v49, v88, v17, 0
    v_dot2_f32_bf16 v50, v89, v16, 0
    v_dot2_f32_bf16 v51, v89, v17, 0
    v_dot2_f32_bf16 v52, v90, v16, 0
    v_dot2_f32_bf16 v53, v90, v17, 0
    v_dot2_f32_bf16 v54, v91, v16, 0
    v_dot2_f32_bf16 v55, v91, v17, 0
    s_waitcnt vmcnt(7)
    v_dot2_f32_bf16 v32, v92, v18, v32
    v_dot2_f32_bf16 v33, v92, v19, v33
    v_dot2_f32_bf16 v34, v93, v18, v34
    v_dot2_f32_bf16 v35, v93, v19, v35
    v_dot2_f32_bf16 v36, v94, v18, v36
    v_dot2_f32_bf16 v37, v94, v19, v37
    v_dot2_f32_bf16 v38, v95, v18, v38
    v_dot2_f32_bf16 v39, v95, v19, v39
    v_dot2_f32_bf16 v40, v96, v18, v40
    v_dot2_f32_bf16 v41, v96, v19, v41
    v_dot2_f32_bf16 v42, v97, v18, v42
    v_dot2_f32_bf16 v43, v97, v19, v43
    v_dot2_f32_bf16 v44, v98, v18, v44
    v_dot2_f32_bf16 v45, v98, v19, v45
    v_dot2_f32_bf16 v46, v99, v18, v46
    v_dot2_f32_bf16 v47, v99, v19, v47
    v_dot2_f32_bf16 v48, v100, v18, v48
    v_dot2_f32_bf16 v49, v100, v19, v49
    v_dot2_f32_bf16 v50, v101, v18, v50
    v_dot2_f32_bf16 v51, v101, v19, v51
    v_dot2_f32_bf16 v52, v102, v18, v52
    v_dot2_f32_bf16 v53, v102, v19, v53
    v_dot2_f32_bf16 v54, v103, v18, v54
    v_dot2_f32_bf16 v55, v103, v19, v55
    s_waitcnt vmcnt(0)
    s_waitcnt lgkmcnt(0)
    v_lshrrev_b32 v24, 16, v25
    v_dot2_f32_bf16 v68, v28, v24, 0
    v_dot2_f32_bf16 v69, v28, v25, 0
    v_dot2_f32_bf16 v70, v29, v24, 0
    v_dot2_f32_bf16 v71, v29, v25, 0
    v_dot2_f32_bf16 v72, v30, v24, 0
    v_dot2_f32_bf16 v73, v30, v25, 0
    v_dot2_f32_bf16 v74, v31, v24, 0
    v_dot2_f32_bf16 v75, v31, v25, 0
    s_nop 2
    v_permlane32_swap_b32 v68, v72
    v_permlane32_swap_b32 v69, v73
    v_permlane32_swap_b32 v70, v74
    v_permlane32_swap_b32 v71, v75
    s_nop 0
    v_add_f32 v68, v68, v72
    v_add_f32 v69, v69, v73
    v_add_f32 v70, v70, v74
    v_add_f32 v71, v71, v75
    s_nop 1
    v_permlane16_swap_b32 v68, v70
    v_permlane16_swap_b32 v69, v71
    s_nop 0
    v_add_f32 v68, v68, v70
    v_add_f32 v69, v69, v71
    s_lshl_b32 s47, s46, 9
    v_add_u32 v15, s47, v3
    ds_write_b64 v15, v[68:69] offset:16384
    v_dot2_f32_bf16 v32, v104, v20, v32
    v_dot2_f32_bf16 v33, v104, v21, v33
    v_dot2_f32_bf16 v34, v105, v20, v34
    v_dot2_f32_bf16 v35, v105, v21, v35
    v_dot2_f32_bf16 v36, v106, v20, v36
    v_dot2_f32_bf16 v37, v106, v21, v37
    v_dot2_f32_bf16 v38, v107, v20, v38
    v_dot2_f32_bf16 v39, v107, v21, v39
    v_dot2_f32_bf16 v40, v108, v20, v40
    v_dot2_f32_bf16 v41, v108, v21, v41
    v_dot2_f32_bf16 v42, v109, v20, v42
    v_dot2_f32_bf16 v43, v109, v21, v43
    v_dot2_f32_bf16 v44, v110, v20, v44
    v_dot2_f32_bf16 v45, v110, v21, v45
    v_dot2_f32_bf16 v46, v111, v20, v46
    v_dot2_f32_bf16 v47, v111, v21, v47
    v_dot2_f32_bf16 v48, v112, v20, v48
    v_dot2_f32_bf16 v49, v112, v21, v49
    v_dot2_f32_bf16 v50, v113, v20, v50
    v_dot2_f32_bf16 v51, v113, v21, v51
    v_dot2_f32_bf16 v52, v114, v20, v52
    v_dot2_f32_bf16 v53, v114, v21, v53
    v_dot2_f32_bf16 v54, v115, v20, v54
    v_dot2_f32_bf16 v55, v115, v21, v55
    v_dot2_f32_bf16 v32, v116, v22, v32
    v_dot2_f32_bf16 v33, v116, v23, v33
    v_dot2_f32_bf16 v34, v117, v22, v34
    v_dot2_f32_bf16 v35, v117, v23, v35
    v_dot2_f32_bf16 v36, v118, v22, v36
    v_dot2_f32_bf16 v37, v118, v23, v37
    v_dot2_f32_bf16 v38, v119, v22, v38
    v_dot2_f32_bf16 v39, v119, v23, v39
    v_dot2_f32_bf16 v40, v120, v22, v40
    v_dot2_f32_bf16 v41, v120, v23, v41
    v_dot2_f32_bf16 v42, v121, v22, v42
    v_dot2_f32_bf16 v43, v121, v23, v43
    v_dot2_f32_bf16 v44, v122, v22, v44
    v_dot2_f32_bf16 v45, v122, v23, v45
    v_dot2_f32_bf16 v46, v123, v22, v46
    v_dot2_f32_bf16 v47, v123, v23, v47
    v_dot2_f32_bf16 v48, v124, v22, v48
    v_dot2_f32_bf16 v49, v124, v23, v49
    v_dot2_f32_bf16 v50, v125, v22, v50
    v_dot2_f32_bf16 v51, v125, v23, v51
    v_dot2_f32_bf16 v52, v126, v22, v52
    v_dot2_f32_bf16 v53, v126, v23, v53
    v_dot2_f32_bf16 v54, v127, v22, v54
    v_dot2_f32_bf16 v55, v127, v23, v55
    s_nop 2
    v_permlane32_swap_b32 v32, v36
    v_permlane32_swap_b32 v33, v37
    v_permlane32_swap_b32 v34, v38
    v_permlane32_swap_b32 v35, v39
    v_permlane32_swap_b32 v40, v44
    v_permlane32_swap_b32 v41, v45
    v_permlane32_swap_b32 v42, v46
    v_permlane32_swap_b32 v43, v47
    v_permlane32_swap_b32 v48, v52
    v_permlane32_swap_b32 v49, v53
    v_permlane32_swap_b32 v50, v54
    v_permlane32_swap_b32 v51, v55
    s_nop 0
    v_add_f32 v32, v32, v36
    v_add_f32 v33, v33, v37
    v_add_f32 v34, v34, v38
    v_add_f32 v35, v35, v39
    v_add_f32 v40, v40, v44
    v_add_f32 v41, v41, v45
    v_add_f32 v42, v42, v46
    v_add_f32 v43, v43, v47
    v_add_f32 v48, v48, v52
    v_add_f32 v49, v49, v53
    v_add_f32 v50, v50, v54
    v_add_f32 v51, v51, v55
    s_nop 1
    v_permlane16_swap_b32 v32, v34
    v_permlane16_swap_b32 v33, v35
    v_permlane16_swap_b32 v40, v42
    v_permlane16_swap_b32 v41, v43
    v_permlane16_swap_b32 v48, v50
    v_permlane16_swap_b32 v49, v51
    s_nop 0
    v_add_f32 v32, v32, v34
    v_add_f32 v33, v33, v35
    v_add_f32 v40, v40, v42
    v_add_f32 v41, v41, v43
    v_add_f32 v48, v48, v50
    v_add_f32 v49, v49, v51
    s_nop 1
    v_add_f32_dpp v32, v32, v32 row_ror:8 row_mask:0xf bank_mask:0xf
    v_add_f32_dpp v33, v33, v33 row_ror:8 row_mask:0xf bank_mask:0xf
    v_add_f32_dpp v40, v40, v40 row_ror:8 row_mask:0xf bank_mask:0xf
    v_add_f32_dpp v41, v41, v41 row_ror:8 row_mask:0xf bank_mask:0xf
    v_add_f32_dpp v48, v48, v48 row_ror:8 row_mask:0xf bank_mask:0xf
    v_add_f32_dpp v49, v49, v49 row_ror:8 row_mask:0xf bank_mask:0xf
    ds_write_b64 v6, v[32:33] offset:0
    ds_write_b64 v6, v[40:41] offset:256
    ds_write_b64 v6, v[48:49] offset:512
    v_mov_b32 v14, 0
    s_lshl_b32 s47, s46, 10
    v_mov_b32 v4, s47
    v_mov_b32 v8, v13
    v_mov_b32 v9, 0
    ds_write_b64 v4, v[8:9] offset:768
    s_lshl_b32 s47, s46, 2
    v_mov_b32 v4, s47
    ds_write_b32 v4, v12 offset:26112
    s_cmp_gt_u32 s46, 11
    s_cbranch_scc1 L_wo_skip
    v_mov_b32 v4, 26640
    s_mov_b32 s60, 0
L_wo_loop:
    ds_read_b32 v5, v4
    s_waitcnt lgkmcnt(0)
    v_readfirstlane_b32 s47, v5
    s_nop 1
    s_cmp_eq_u32 s47, 4
    s_cbranch_scc1 L_wo_go
    s_add_u32 s60, s60, 1
    s_cmp_lt_u32 s60, 4000000
    s_cbranch_scc0 L_wo_go
    s_sleep 4
    s_branch L_wo_loop
L_wo_go:
    buffer_load_dwordx4 v[56:59], v7, s[20:23], s54 offen
    buffer_load_dwordx4 v[60:63], v7, s[20:23], s55 offen
    buffer_load_dwordx4 v[64:67], v7, s[20:23], s56 offen
L_wo_skip:
    s_waitcnt lgkmcnt(0)
    s_barrier
    s_cmp_lt_u32 s46, 12
    s_cbranch_scc1 L_wo_late_done
    buffer_load_dwordx4 v[56:59], v7, s[20:23], s54 offen
    buffer_load_dwordx4 v[60:63], v7, s[20:23], s55 offen
    buffer_load_dwordx4 v[64:67], v7, s[20:23], s56 offen
L_wo_late_done:
    s_cmp_gt_u32 s46, 3
    s_cbranch_scc1 L_pub1_done
    s_cmp_lt_u32 s46, 2
    s_cbranch_scc1 L_pub1
    v_lshlrev_b32 v4, 2, v0
    ds_read_b32 v72, v4 offset:15872
    ds_read_b32 v73, v4 offset:16384
    ds_read_b32 v74, v4 offset:16896
    ds_read_b32 v75, v4 offset:17408
    ds_read_b32 v76, v4 offset:17920
    ds_read_b32 v77, v4 offset:18432
    ds_read_b32 v78, v4 offset:18944
    ds_read_b32 v79, v4 offset:19456
    ds_read_b32 v80, v4 offset:19968
    ds_read_b32 v81, v4 offset:20480
    ds_read_b32 v82, v4 offset:20992
    ds_read_b32 v83, v4 offset:21504
    ds_read_b32 v84, v4 offset:22016
    ds_read_b32 v85, v4 offset:22528
    ds_read_b32 v86, v4 offset:23040
    ds_read_b32 v87, v4 offset:23552
    s_waitcnt lgkmcnt(0)
    v_add_f32 v72, v72, v73
    v_add_f32 v72, v72, v74
    v_add_f32 v72, v72, v75
    v_add_f32 v72, v72, v76
    v_add_f32 v72, v72, v77
    v_add_f32 v72, v72, v78
    v_add_f32 v72, v72, v79
    v_add_f32 v72, v72, v80
    v_add_f32 v72, v72, v81
    v_add_f32 v72, v72, v82
    v_add_f32 v72, v72, v83
    v_add_f32 v72, v72, v84
    v_add_f32 v72, v72, v85
    v_add_f32 v72, v72, v86
    v_add_f32 v72, v72, v87
    ds_write_b32 v4, v72 offset:26176
    s_branch L_pub1_done
L_pub1:
    v_lshrrev_b32 v4, 3, v0
    v_and_b32 v5, 7, v0
    v_mul_u32_u24 v8, 48, v4
    v_lshlrev_b32 v9, 3, v5
    v_add_u32 v8, v8, v9
    v_mov_b32 v9, 768
    v_cmp_gt_u32 vcc, 6, v5
    s_nop 1
    v_cndmask_b32 v8, v9, v8, vcc
    s_mov_b64 s[58:59], vcc
    v_mov_b32 v9, 0
    ds_read_b128 v[104:107], v9 offset:26112
    ds_read_b128 v[108:111], v9 offset:26128
    ds_read_b128 v[112:115], v9 offset:26144
    ds_read_b128 v[116:119], v9 offset:26160
    ds_read_b64 v[72:73], v8 offset:0
    ds_read_b64 v[74:75], v8 offset:1024
    ds_read_b64 v[76:77], v8 offset:2048
    ds_read_b64 v[78:79], v8 offset:3072
    ds_read_b64 v[80:81], v8 offset:4096
    ds_read_b64 v[82:83], v8 offset:5120
    ds_read_b64 v[84:85], v8 offset:6144
    ds_read_b64 v[86:87], v8 offset:7168
    ds_read_b64 v[88:89], v8 offset:8192
    ds_read_b64 v[90:91], v8 offset:9216
    ds_read_b64 v[92:93], v8 offset:10240
    ds_read_b64 v[94:95], v8 offset:11264
    ds_read_b64 v[96:97], v8 offset:12288
    ds_read_b64 v[98:99], v8 offset:13312
    ds_read_b64 v[100:101], v8 offset:14336
    ds_read_b64 v[102:103], v8 offset:15360
    s_waitcnt lgkmcnt(15)
    v_max3_f32 v12, v104, v105, v106
    v_max3_f32 v12, v12, v107, v108
    v_max3_f32 v12, v12, v109, v110
    v_max3_f32 v12, v12, v111, v112
    v_max3_f32 v12, v12, v113, v114
    v_max3_f32 v12, v12, v115, v116
    v_max3_f32 v12, v12, v117, v118
    v_max_f32 v12, v12, v119
    v_sub_f32 v104, v104, v12
    v_mul_f32 v104, 0x3fb8aa3b, v104
    v_exp_f32 v104, v104
    v_sub_f32 v105, v105, v12
    v_mul_f32 v105, 0x3fb8aa3b, v105
    v_exp_f32 v105, v105
    v_sub_f32 v106, v106, v12
    v_mul_f32 v106, 0x3fb8aa3b, v106
    v_exp_f32 v106, v106
    v_sub_f32 v107, v107, v12
    v_mul_f32 v107, 0x3fb8aa3b, v107
    v_exp_f32 v107, v107
    v_sub_f32 v108, v108, v12
    v_mul_f32 v108, 0x3fb8aa3b, v108
    v_exp_f32 v108, v108
    v_sub_f32 v109, v109, v12
    v_mul_f32 v109, 0x3fb8aa3b, v109
    v_exp_f32 v109, v109
    v_sub_f32 v110, v110, v12
    v_mul_f32 v110, 0x3fb8aa3b, v110
    v_exp_f32 v110, v110
    v_sub_f32 v111, v111, v12
    v_mul_f32 v111, 0x3fb8aa3b, v111
    v_exp_f32 v111, v111
    v_sub_f32 v112, v112, v12
    v_mul_f32 v112, 0x3fb8aa3b, v112
    v_exp_f32 v112, v112
    v_sub_f32 v113, v113, v12
    v_mul_f32 v113, 0x3fb8aa3b, v113
    v_exp_f32 v113, v113
    v_sub_f32 v114, v114, v12
    v_mul_f32 v114, 0x3fb8aa3b, v114
    v_exp_f32 v114, v114
    v_sub_f32 v115, v115, v12
    v_mul_f32 v115, 0x3fb8aa3b, v115
    v_exp_f32 v115, v115
    v_sub_f32 v116, v116, v12
    v_mul_f32 v116, 0x3fb8aa3b, v116
    v_exp_f32 v116, v116
    v_sub_f32 v117, v117, v12
    v_mul_f32 v117, 0x3fb8aa3b, v117
    v_exp_f32 v117, v117
    v_sub_f32 v118, v118, v12
    v_mul_f32 v118, 0x3fb8aa3b, v118
    v_exp_f32 v118, v118
    v_sub_f32 v119, v119, v12
    v_mul_f32 v119, 0x3fb8aa3b, v119
    v_exp_f32 v119, v119
    v_lshlrev_b32 v4, 10, v4
    v_lshlrev_b32 v5, 4, v5
    v_add_u32 v4, v4, v5
    s_lshl_b32 s47, s44, 14
    s_lshl_b32 s48, s45, 7
    s_add_u32 s47, s47, s48
    s_add_u32 s47, s47, 0
    v_add_u32 v4, s47, v4
    s_waitcnt lgkmcnt(0)
    v_mul_f32 v72, v72, v104
    v_mul_f32 v73, v73, v104
    v_fmac_f32 v72, v74, v105
    v_fmac_f32 v73, v75, v105
    v_fmac_f32 v72, v76, v106
    v_fmac_f32 v73, v77, v106
    v_fmac_f32 v72, v78, v107
    v_fmac_f32 v73, v79, v107
    v_fmac_f32 v72, v80, v108
    v_fmac_f32 v73, v81, v108
    v_fmac_f32 v72, v82, v109
    v_fmac_f32 v73, v83, v109
    v_fmac_f32 v72, v84, v110
    v_fmac_f32 v73, v85, v110
    v_fmac_f32 v72, v86, v111
    v_fmac_f32 v73, v87, v111
    v_fmac_f32 v72, v88, v112
    v_fmac_f32 v73, v89, v112
    v_fmac_f32 v72, v90, v113
    v_fmac_f32 v73, v91, v113
    v_fmac_f32 v72, v92, v114
    v_fmac_f32 v73, v93, v114
    v_fmac_f32 v72, v94, v115
    v_fmac_f32 v73, v95, v115
    v_fmac_f32 v72, v96, v116
    v_fmac_f32 v73, v97, v116
    v_fmac_f32 v72, v98, v117
    v_fmac_f32 v73, v99, v117
    v_fmac_f32 v72, v100, v118
    v_fmac_f32 v73, v101, v118
    v_fmac_f32 v72, v102, v119
    v_fmac_f32 v73, v103, v119
    v_cndmask_b32 v73, v72, v73, s[58:59]
    v_cndmask_b32 v72, v12, v72, s[58:59]
    v_mov_b32 v74, s52
    v_mov_b32 v75, s53
    buffer_store_dwordx4 v[72:75], v4, s[40:43], 0 offen sc1
L_pub1_done:
    s_lshl_b32 s47, s44, 14
    s_lshl_b32 s48, s46, 10
    s_add_u32 s47, s47, s48
    s_add_u32 s47, s47, 0
    v_lshlrev_b32 v4, 4, v1
    v_add_u32 v4, s47, v4
    v_or_b32 v9, 7, v1
    v_lshlrev_b32 v9, 2, v9
    v_lshrrev_b32 v5, 4, v1
    v_and_b32 v10, 1, v5
    v_lshlrev_b32 v10, 3, v10
    v_lshrrev_b32 v5, 1, v5
    v_add_u32 v10, v10, v5
    v_lshlrev_b32 v10, 2, v10
    v_bfe_u32 v11, v1, 3, 1
    s_mov_b32 s60, 0
    s_cmp_eq_u32 s46, 0
    s_cbranch_scc1 L_poll1
    v_mov_b32 v5, 26644
L_lead_loop:
    ds_read_b32 v8, v5
    s_waitcnt lgkmcnt(0)
    v_readfirstlane_b32 s47, v8
    s_nop 1
    s_cmp_eq_u32 s47, 1
    s_cbranch_scc1 L_poll1
    s_add_u32 s60, s60, 1
    s_cmp_lt_u32 s60, 4000000
    s_cbranch_scc0 L_poll1
    s_sleep 1
    s_branch L_lead_loop
L_poll1:
    buffer_load_dwordx4 v[72:75], v4, s[40:43], 0 offen sc1
    s_waitcnt vmcnt(0)
    v_cmp_ne_u32 vcc, s52, v74
    v_cmp_ne_u32 s[56:57], s53, v75
    s_nop 1
    s_or_b64 vcc, vcc, s[56:57]
    s_cmp_eq_u64 vcc, 0
    s_cbranch_scc1 L_poll1_ok
    s_add_u32 s60, s60, 1
    s_cmp_lt_u32 s60, 4000000
    s_cbranch_scc1 L_poll1
L_poll1_ok:
    s_cmp_lg_u32 s46, 0
    s_cbranch_scc1 L_poll1_done
    v_mov_b32 v5, 26644
    v_mov_b32 v8, 1
    ds_write_b32 v5, v8
L_poll1_done:
    ds_bpermute_b32 v76, v9, v72
    ds_bpermute_b32 v77, v9, v73
    s_waitcnt lgkmcnt(0)
    v_mov_b32 v78, v76
    s_nop 1
    v_max_f32_dpp v78, v78, v78 row_ror:8 row_mask:0xf bank_mask:0xf
    s_nop 1
    v_mov_b32 v79, v78
    s_nop 1
    v_permlane16_swap_b32 v78, v79
    s_nop 0
    v_max_f32 v78, v78, v79
    s_nop 1
    v_mov_b32 v79, v78
    s_nop 1
    v_permlane32_swap_b32 v78, v79
    s_nop 0
    v_max_f32 v78, v78, v79
    v_sub_f32 v76, v76, v78
    v_mul_f32 v76, 0x3fb8aa3b, v76
    v_exp_f32 v76, v76
    s_nop 0
    v_mul_f32 v77, v76, v77
    v_mul_f32 v72, v76, v72
    v_mul_f32 v73, v76, v73
    v_add_f32_dpp v77, v77, v77 row_ror:8 row_mask:0xf bank_mask:0xf
    v_add_f32_dpp v72, v72, v72 row_ror:8 row_mask:0xf bank_mask:0xf
    v_add_f32_dpp v73, v73, v73 row_ror:8 row_mask:0xf bank_mask:0xf
    v_mov_b32 v78, v77
    v_mov_b32 v79, v72
    v_mov_b32 v80, v73
    v_permlane16_swap_b32 v77, v78
    v_permlane16_swap_b32 v72, v79
    v_permlane16_swap_b32 v73, v80
    v_add_f32 v77, v77, v78
    v_add_f32 v72, v72, v79
    v_add_f32 v73, v73, v80
    v_mov_b32 v78, v77
    v_mov_b32 v79, v72
    v_mov_b32 v80, v73
    v_permlane32_swap_b32 v77, v78
    v_permlane32_swap_b32 v72, v79
    v_permlane32_swap_b32 v73, v80
    v_add_f32 v77, v77, v78
    v_add_f32 v72, v72, v79
    v_add_f32 v73, v73, v80
    v_rcp_f32 v78, v77
    v_cmp_eq_u32 vcc, 1, v11
    s_nop 1
    v_cndmask_b32 v72, v72, v73, vcc
    v_mul_f32 v79, v72, v78
    v_fma_f32 v80, -v79, v77, v72
    v_fma_f32 v79, v80, v78, v79
    v_cvt_pk_bf16_f32 v79, v79, v79
    v_and_b32 v79, 0xffff0000, v79
    ds_bpermute_b32 v73, v10, v79 offset:0
    ds_bpermute_b32 v75, v10, v79 offset:8
    ds_bpermute_b32 v77, v10, v79 offset:16
    s_waitcnt lgkmcnt(0)
    v_lshrrev_b32 v72, 16, v73
    v_lshrrev_b32 v74, 16, v75
    v_lshrrev_b32 v76, 16, v77
    v_dot2_f32_bf16 v80, v56, v72, 0
    v_dot2_f32_bf16 v81, v56, v73, 0
    v_dot2_f32_bf16 v82, v57, v72, 0
    v_dot2_f32_bf16 v83, v57, v73, 0
    v_dot2_f32_bf16 v84, v58, v72, 0
    v_dot2_f32_bf16 v85, v58, v73, 0
    v_dot2_f32_bf16 v86, v59, v72, 0
    v_dot2_f32_bf16 v87, v59, v73, 0
    v_dot2_f32_bf16 v80, v60, v74, v80
    v_dot2_f32_bf16 v81, v60, v75, v81
    v_dot2_f32_bf16 v82, v61, v74, v82
    v_dot2_f32_bf16 v83, v61, v75, v83
    v_dot2_f32_bf16 v84, v62, v74, v84
    v_dot2_f32_bf16 v85, v62, v75, v85
    v_dot2_f32_bf16 v86, v63, v74, v86
    v_dot2_f32_bf16 v87, v63, v75, v87
    v_dot2_f32_bf16 v80, v64, v76, v80
    v_dot2_f32_bf16 v81, v64, v77, v81
    v_dot2_f32_bf16 v82, v65, v76, v82
    v_dot2_f32_bf16 v83, v65, v77, v83
    v_dot2_f32_bf16 v84, v66, v76, v84
    v_dot2_f32_bf16 v85, v66, v77, v85
    v_dot2_f32_bf16 v86, v67, v76, v86
    v_dot2_f32_bf16 v87, v67, v77, v87
    s_nop 2
    v_permlane32_swap_b32 v80, v84
    v_permlane32_swap_b32 v81, v85
    v_permlane32_swap_b32 v82, v86
    v_permlane32_swap_b32 v83, v87
    s_nop 0
    v_add_f32 v80, v80, v84
    v_add_f32 v81, v81, v85
    v_add_f32 v82, v82, v86
    v_add_f32 v83, v83, v87
    s_nop 1
    v_permlane16_swap_b32 v80, v82
    v_permlane16_swap_b32 v81, v83
    s_nop 0
    v_add_f32 v80, v80, v82
    v_add_f32 v81, v81, v83
    s_lshl_b32 s47, s46, 10
    v_add_u32 v4, s47, v3
    ds_write_b64 v4, v[80:81] offset:27648
    s_waitcnt lgkmcnt(0)
    s_barrier
    s_cmp_gt_u32 s46, 1
    s_cbranch_scc1 L_pub2_done
    v_lshrrev_b32 v5, 3, v0
    v_and_b32 v8, 7, v0
    v_mul_u32_u24 v4, 5, v5
    v_add_u32 v4, v4, v8
    v_lshlrev_b32 v4, 2, v4
    ds_read_b32 v72, v4 offset:27648
    ds_read_b32 v73, v4 offset:28672
    ds_read_b32 v74, v4 offset:29696
    ds_read_b32 v75, v4 offset:30720
    ds_read_b32 v76, v4 offset:31744
    ds_read_b32 v77, v4 offset:32768
    ds_read_b32 v78, v4 offset:33792
    ds_read_b32 v79, v4 offset:34816
    ds_read_b32 v80, v4 offset:35840
    ds_read_b32 v81, v4 offset:36864
    ds_read_b32 v82, v4 offset:37888
    ds_read_b32 v83, v4 offset:38912
    ds_read_b32 v84, v4 offset:39936
    ds_read_b32 v85, v4 offset:40960
    ds_read_b32 v86, v4 offset:41984
    ds_read_b32 v87, v4 offset:43008
    ds_read_b32 v88, v4 offset:26688
    v_lshlrev_b32 v5, 12, v5
    v_lshlrev_b32 v9, 4, v8
    v_add_u32 v5, v5, v9
    s_lshl_b32 s47, s45, 16
    s_lshl_b32 s48, s44, 7
    s_add_u32 s47, s47, s48
    s_add_u32 s47, s47, 1048576
    v_add_u32 v5, s47, v5
    s_waitcnt lgkmcnt(0)
    v_add_f32 v72, v72, v73
    v_add_f32 v72, v72, v74
    v_add_f32 v72, v72, v75
    v_add_f32 v72, v72, v76
    v_add_f32 v72, v72, v77
    v_add_f32 v72, v72, v78
    v_add_f32 v72, v72, v79
    v_add_f32 v72, v72, v80
    v_add_f32 v72, v72, v81
    v_add_f32 v72, v72, v82
    v_add_f32 v72, v72, v83
    v_add_f32 v72, v72, v84
    v_add_f32 v72, v72, v85
    v_add_f32 v72, v72, v86
    v_add_f32 v72, v72, v87
    v_mov_b32 v73, v88
    v_mov_b32 v74, s52
    v_mov_b32 v75, s53
    v_cmp_gt_u32 vcc, 5, v8
    s_and_saveexec_b64 s[62:63], vcc
    buffer_store_dwordx4 v[72:75], v5, s[40:43], 0 offen sc1
    s_mov_b64 exec, s[62:63]
L_pub2_done:
    s_and_b32 s47, s44, 1
    s_or_b32 s47, s47, s46
    s_cmp_lg_u32 s47, 0
    s_cbranch_scc1 L_end
    s_lshr_b32 s49, s44, 1
    v_and_b32 v5, 7, v1
    s_mul_i32 s47, s49, 5
    v_add_u32 v8, s47, v5
    v_lshlrev_b32 v12, 1, v8
    s_mul_i32 s47, s45, 160
    buffer_load_ushort v100, v12, s[4:7], s47 offen
    s_lshl_b32 s47, s45, 16
    s_lshl_b32 s48, s49, 12
    s_add_u32 s47, s47, s48
    s_add_u32 s47, s47, 1048576
    v_lshlrev_b32 v4, 4, v1
    v_add_u32 v4, s47, v4
    v_cmp_gt_u32 vcc, 5, v5
    s_nop 1
    s_mov_b64 s[58:59], vcc
    s_mov_b32 s60, 0
L_poll2:
    buffer_load_dwordx4 v[72:75], v4, s[40:43], 0 offen offset:0 sc1
    buffer_load_dwordx4 v[76:79], v4, s[40:43], 0 offen offset:1024 sc1
    buffer_load_dwordx4 v[80:83], v4, s[40:43], 0 offen offset:2048 sc1
    buffer_load_dwordx4 v[84:87], v4, s[40:43], 0 offen offset:3072 sc1
    s_waitcnt vmcnt(0)
    v_xor_b32 v90, s52, v74
    v_xor_b32 v91, s53, v75
    v_or_b32 v90, v90, v91
    v_xor_b32 v91, s52, v78
    v_or_b32 v90, v90, v91
    v_xor_b32 v91, s53, v79
    v_or_b32 v90, v90, v91
    v_xor_b32 v91, s52, v82
    v_or_b32 v90, v90, v91
    v_xor_b32 v91, s53, v83
    v_or_b32 v90, v90, v91
    v_xor_b32 v91, s52, v86
    v_or_b32 v90, v90, v91
    v_xor_b32 v91, s53, v87
    v_or_b32 v90, v90, v91
    v_cmp_ne_u32 vcc, 0, v90
    s_nop 1
    s_and_b64 vcc, vcc, s[58:59]
    s_cmp_eq_u64 vcc, 0
    s_cbranch_scc1 L_poll2_done
    s_add_u32 s60, s60, 1
    s_cmp_lt_u32 s60, 400000
    s_cbranch_scc0 L_poll2_done
    s_branch L_poll2
L_poll2_done:
    v_add_f32 v72, v72, v76
    v_add_f32 v73, v73, v77
    v_add_f32 v72, v72, v80
    v_add_f32 v73, v73, v81
    v_add_f32 v72, v72, v84
    v_add_f32 v73, v73, v85
    s_nop 0
    v_add_f32_dpp v72, v72, v72 row_ror:8 row_mask:0xf bank_mask:0xf
    v_add_f32_dpp v73, v73, v73 row_ror:8 row_mask:0xf bank_mask:0xf
    s_nop 0
    v_mov_b32 v84, v72
    v_mov_b32 v85, v73
    s_nop 0
    v_permlane16_swap_b32 v72, v84
    v_permlane16_swap_b32 v73, v85
    v_add_f32 v72, v72, v84
    v_add_f32 v73, v73, v85
    s_nop 0
    v_mov_b32 v84, v72
    v_mov_b32 v85, v73
    s_nop 0
    v_permlane32_swap_b32 v72, v84
    v_permlane32_swap_b32 v73, v85
    v_add_f32 v72, v72, v84
    v_add_f32 v73, v73, v85
    v_cvt_pk_bf16_f32 v72, v72, v72
    v_and_b32 v72, 0xffff0000, v72
    v_cvt_pk_bf16_f32 v73, v73, v73
    v_and_b32 v73, 0xffff0000, v73
    v_lshlrev_b32 v100, 16, v100
    v_add_f32 v72, v100, v72
    v_cvt_pk_bf16_f32 v72, v72, v72
    v_and_b32 v72, 0xffff0000, v72
    v_add_f32 v72, v72, v73
    v_cvt_pk_bf16_f32 v72, v72, v72
    s_mul_i32 s47, s45, 160
    s_mov_b64 exec, 31
    buffer_store_short v72, v12, s[32:35], s47 offen
    s_mov_b64 exec, -1
L_end:
    s_endpgm
.section .rodata,"a"
.p2align 6
.amdhsa_kernel parallel_sum__sliding_block_cached__dense_activation_relu__decode_kernel
  .amdhsa_next_free_vgpr 128
  .amdhsa_next_free_sgpr 102
  .amdhsa_accum_offset 128
  .amdhsa_group_segment_fixed_size 0
  .amdhsa_kernarg_size 88
  .amdhsa_user_sgpr_count 2
  .amdhsa_user_sgpr_kernarg_segment_ptr 1
  .amdhsa_system_sgpr_workgroup_id_x 1
.end_amdhsa_kernel
```
